```python
import torch

def _softmax(x, axis=-1):
    return torch.softmax(x, dim=axis)
def _gelu(x):
    return torch.nn.functional.gelu(x, approximate="tanh")
def _silu(x):
    return torch.nn.functional.silu(x)
def _sigmoid(x):
    return torch.sigmoid(x)
def _layernorm(x, axis=-1, eps=1e-5):
    m = x.mean(dim=axis, keepdim=True)
    v = x.var(dim=axis, keepdim=True, unbiased=False)
    return (x - m) / torch.sqrt(v + eps)
def _scatter_add(tgt, idx, src, axis=0):
    return tgt.clone().index_add_(axis, idx, src)
def _segment_sum(src, seg, n):
    out = torch.zeros((n,) + src.shape[1:], dtype=src.dtype)
    return out.index_add_(0, seg, src)
def _pad(x, pw):
    flat = tuple(v for pair in reversed(pw) for v in pair)
    return torch.nn.functional.pad(x, flat)

kernel_name = 'standalone__gqa_block_cached__decode'

def setup_inputs():

    _w = (lambda a: (lambda t: t.to(torch.bfloat16) if t.is_floating_point() else t)(torch.as_tensor(a)))
    B, Sq, D = 4, 1, 512
    Hq, Hkv, Sk, Dh = 32, 8, 16384, 128
    assert Hq % Hkv == 0, (Hq, Hkv)
    return {
        "x": _w((lambda *s: torch.randn(*s, dtype=torch.bfloat16) * 0.8)(B, Sq, D)),
        "k_cache": _w((lambda *s: torch.randn(*s, dtype=torch.bfloat16) * 0.8)(B, Hkv, Sk, Dh)),
        "v_cache": _w((lambda *s: torch.randn(*s, dtype=torch.bfloat16) * 0.05)(B, Hkv, Sk, Dh)),
        "wq": _w((lambda *s: torch.randn(*s, dtype=torch.bfloat16) * 0.8)(D, Hq * Dh) * (D ** -0.5)),
        "wo": _w((lambda *s: torch.randn(*s, dtype=torch.bfloat16) * 0.05)(Hq * Dh, D) * ((Hq * Dh) ** -0.5)),
    }

def reference(x, k_cache, v_cache, wq, wo):
    B, Sq, D = x.shape
    Hq, Dh = 32, 128
    Hkv = k_cache.shape[1]
    rep = Hq // Hkv
    q = (lambda x, *d: x.permute(*d))((x @ wq).reshape(B, Sq, Hq, Dh), 0, 2, 1, 3)
    k = (lambda x, n, axis: torch.repeat_interleave(x, n, dim=axis))(k_cache, rep, axis=1)
    v = (lambda x, n, axis: torch.repeat_interleave(x, n, dim=axis))(v_cache, rep, axis=1)
    scores = torch.einsum("bhqd,bhkd->bhqk", q, k) * (Dh ** -0.5)
    p = _softmax(scores, axis=-1)
    o = torch.einsum("bhqk,bhkd->bhqd", p, v)
    return (lambda x, *d: x.permute(*d))(o, 0, 2, 1, 3).reshape(B, Sq, Hq * Dh) @ wo
```

```asm
; @launch grid=(256,1,1) block=(384,1,1) lds=149504
.amdgcn_target "amdgcn-amd-amdhsa--gfx950"
.text
.globl standalone__gqa_block_cached__decode_kernel
.p2align 8
.type standalone__gqa_block_cached__decode_kernel,@function
standalone__gqa_block_cached__decode_kernel:
    s_cmp_ge_u32 s2, 256
    s_cbranch_scc1 L_end0
    s_load_dwordx16 s[4:19], s[0:1], 0
    v_lshrrev_b32 v1, 6, v0
    v_and_b32 v0, 63, v0
    s_lshr_b32 s32, s2, 3
    v_readfirstlane_b32 s3, v1
    s_and_b32 s33, s2, 7
    s_lshr_b32 s34, s2, 6
    s_and_b32 s35, s32, 7
    s_cmp_eq_u32 s3, 4
    s_cbranch_scc1 L_loader
    s_cmp_lg_u32 s3, 5
    s_cbranch_scc1 L_cons0
    s_getpc_b64 s[28:29]
L_pc:
    v_lshlrev_b32 v2, 7, v0
    v_min_u32 v2, L_codeend - L_pc - 4, v2
    global_load_dword v100, v2, s[28:29]
    s_barrier
    s_branch L_claimer
L_cons0:
    s_barrier
    s_branch L_cons
L_end0:
    s_endpgm
L_loader:
    s_setprio 3
    v_lshlrev_b32 v6, 4, v0
    v_mov_b32 v12, 0
    v_mov_b32 v13, 0
    v_mov_b32 v14, 0
    v_mov_b32 v15, 0
    v_add_u32 v10, 147456, v6
    ds_write_b128 v10, v[12:15]
    v_mov_b32 v10, 147456
    v_mov_b32 v11, 2
    ds_write_b32 v10, v11 offset:12
    v_lshrrev_b32 v7, 2, v0
    v_and_b32 v8, 3, v0
    v_lshlrev_b32 v7, 13, v7
    v_lshl_add_u32 v20, v8, 4, v7
    v_add_u32 v21, 130048, v20
    v_add_u32 v22, 130048, v21
    v_add_u32 v23, 130048, v22
    s_lshr_b32 s45, s34, 1
    s_lshl_b32 s45, s45, 21
    s_and_b32 s46, s2, 63
    s_lshl_b32 s46, s46, 7
    s_add_u32 s45, s45, s46
    s_and_b32 s46, s2, 64
    s_add_u32 s45, s45, s46
    s_mov_b32 s30, 0x400000
    s_mov_b32 s31, 0x20000
    s_mov_b32 m0, 131072
    s_waitcnt lgkmcnt(0)
    s_mov_b32 s28, s10
    s_mov_b32 s29, s11
L_wq:
    buffer_load_dwordx4 v20, s[28:31], s45 offen offset:0 nt lds
    buffer_load_dwordx4 v21, s[28:31], s45 offen offset:1024 nt lds
    buffer_load_dwordx4 v22, s[28:31], s45 offen offset:2048 nt lds
    buffer_load_dwordx4 v23, s[28:31], s45 offen offset:3072 nt lds
    s_add_u32 m0, m0, 4096
    s_add_u32 s45, s45, 524288
    s_cmp_lt_u32 m0, 147456
    s_cbranch_scc1 L_wq
    s_barrier
    v_lshrrev_b32 v7, 4, v0
    v_xor_b32 v7, v7, v0
    v_lshlrev_b32 v2, 4, v7
    v_xor_b32 v3, 64, v2
    v_xor_b32 v4, 128, v2
    v_xor_b32 v5, 192, v2
    s_lshl_b32 s40, s32, 22
    s_mov_b32 s42, 0
    s_mov_b32 s43, 0
    v_mov_b32 v11, 0
    s_mov_b32 s51, 0
    v_mov_b32 v9, 147456
    s_mov_b32 s20, s6
    s_mov_b32 s21, s7
    s_mov_b32 s22, 0x8000000
    s_mov_b32 s23, 0x20000
    s_mov_b32 s24, s8
    s_mov_b32 s25, s9
    s_mov_b32 s26, 0x8000000
    s_mov_b32 s27, 0x20000
    s_mul_i32 s38, s32, 4
    s_mov_b32 s46, s33
    s_lshr_b32 s47, s46, 3
    s_add_u32 s48, s46, s32
    s_add_u32 s47, s47, s38
    s_and_b32 s48, s48, 7
    s_and_b32 s47, s47, 63
    s_lshl_b32 s48, s48, 12
    s_lshl_b32 s47, s47, 16
    s_add_u32 s44, s48, s40
    s_add_u32 s44, s44, s47
    s_add_u32 m0, s42, 0
    s_add_u32 s45, s44, 0
    buffer_load_dwordx4 v2, s[20:23], s45 offen offset:0 nt lds
    buffer_load_dwordx4 v3, s[20:23], s45 offen offset:1024 nt lds
    buffer_load_dwordx4 v4, s[20:23], s45 offen offset:2048 nt lds
    buffer_load_dwordx4 v5, s[20:23], s45 offen offset:3072 nt lds
    s_add_u32 m0, s42, 4096
    s_add_u32 s45, s44, 32768
    buffer_load_dwordx4 v2, s[20:23], s45 offen offset:0 nt lds
    buffer_load_dwordx4 v3, s[20:23], s45 offen offset:1024 nt lds
    buffer_load_dwordx4 v4, s[20:23], s45 offen offset:2048 nt lds
    buffer_load_dwordx4 v5, s[20:23], s45 offen offset:3072 nt lds
    s_mov_b32 s41, 1
    s_mov_b32 s42, 16384
L_ld:
    s_mov_b32 s39, s44
    s_lshl_b32 s46, s41, 3
    s_add_u32 s46, s46, s33
    s_cmp_lt_u32 s41, 60
    s_cbranch_scc1 L_got
    s_waitcnt lgkmcnt(0)
    v_readfirstlane_b32 s46, v17
    s_mov_b32 s52, 524288
    s_cmp_lg_u32 s46, 0
    s_cbranch_scc1 L_mb
L_wmb:
    ds_read_b32 v17, v16 offset:256
    s_sub_u32 s52, s52, 1
    s_cbranch_scc1 L_drain
    s_waitcnt lgkmcnt(0)
    v_readfirstlane_b32 s46, v17
    s_cmp_lg_u32 s46, 0
    s_cbranch_scc0 L_wmb
L_mb:
    s_cmp_gt_u32 s46, 512
    s_cbranch_scc1 L_drain
    s_sub_u32 s46, s46, 1
L_got:
    s_lshr_b32 s47, s46, 3
    s_add_u32 s48, s46, s32
    s_add_u32 s47, s47, s38
    s_and_b32 s48, s48, 7
    s_and_b32 s47, s47, 63
    s_lshl_b32 s48, s48, 12
    s_lshl_b32 s47, s47, 16
    s_add_u32 s44, s48, s40
    s_add_u32 s44, s44, s47
    s_waitcnt lgkmcnt(0)
    v_min_u32 v12, v12, v13
    s_mov_b32 s52, 524288
    v_readfirstlane_b32 s50, v12
    s_cmp_ge_u32 s50, s51
    s_cbranch_scc1 L_freea
L_wfreea:
    ds_read_b64 v[12:13], v9 offset:8
    s_sub_u32 s52, s52, 1
    s_cbranch_scc1 L_freea
    s_waitcnt lgkmcnt(0)
    v_min_u32 v12, v12, v13
    s_nop 0
    v_readfirstlane_b32 s50, v12
    s_cmp_ge_u32 s50, s51
    s_cbranch_scc0 L_wfreea
L_freea:
    s_add_u32 m0, s42, 0
    s_add_u32 s45, s44, 0
    s_waitcnt vmcnt(20)
    buffer_load_dwordx4 v2, s[20:23], s45 offen offset:0 nt lds
    s_waitcnt vmcnt(20)
    buffer_load_dwordx4 v3, s[20:23], s45 offen offset:1024 nt lds
    s_waitcnt vmcnt(20)
    buffer_load_dwordx4 v4, s[20:23], s45 offen offset:2048 nt lds
    s_waitcnt vmcnt(20)
    buffer_load_dwordx4 v5, s[20:23], s45 offen offset:3072 nt lds
    s_add_u32 m0, s42, 4096
    s_add_u32 s45, s44, 32768
    s_waitcnt vmcnt(20)
    buffer_load_dwordx4 v2, s[20:23], s45 offen offset:0 nt lds
    s_add_u32 s43, s43, 1
    v_max_i32 v11, s43, v11
    ds_write_b32 v10, v11
    s_waitcnt vmcnt(20)
    buffer_load_dwordx4 v3, s[20:23], s45 offen offset:1024 nt lds
    s_waitcnt vmcnt(20)
    buffer_load_dwordx4 v4, s[20:23], s45 offen offset:2048 nt lds
    s_waitcnt vmcnt(20)
    buffer_load_dwordx4 v5, s[20:23], s45 offen offset:3072 nt lds
    s_add_u32 m0, s42, 8192
    s_add_u32 s45, s39, 0
    s_waitcnt vmcnt(20)
    buffer_load_dwordx4 v6, s[24:27], s45 offen offset:0 nt lds
    s_waitcnt vmcnt(20)
    buffer_load_dwordx4 v6, s[24:27], s45 offen offset:1024 nt lds
    s_waitcnt vmcnt(20)
    buffer_load_dwordx4 v6, s[24:27], s45 offen offset:2048 nt lds
    s_waitcnt vmcnt(20)
    buffer_load_dwordx4 v6, s[24:27], s45 offen offset:3072 nt lds
    s_add_u32 s50, s42, 16384
    s_and_b32 s50, s50, 131071
    s_lshr_b32 s50, s50, 11
    v_add_u32 v9, s50, v10
    s_add_u32 s51, s41, 1
    s_lshr_b32 s51, s51, 3
    s_lshl_b32 s51, s51, 1
    ds_read_b64 v[12:13], v9 offset:8
    s_sub_i32 s50, s41, 59
    s_max_i32 s50, s50, 0
    v_lshl_add_u32 v16, s50, 2, v10
    ds_read_b32 v17, v16 offset:256
    s_add_u32 m0, s42, 12288
    s_add_u32 s45, s39, 32768
    s_waitcnt vmcnt(20)
    buffer_load_dwordx4 v6, s[24:27], s45 offen offset:0 nt lds
    s_add_u32 s43, s43, 1
    v_max_i32 v11, s43, v11
    ds_write_b32 v10, v11
    s_waitcnt vmcnt(20)
    buffer_load_dwordx4 v6, s[24:27], s45 offen offset:1024 nt lds
    s_waitcnt vmcnt(20)
    buffer_load_dwordx4 v6, s[24:27], s45 offen offset:2048 nt lds
    s_waitcnt vmcnt(20)
    buffer_load_dwordx4 v6, s[24:27], s45 offen offset:3072 nt lds
    s_add_u32 s42, s42, 16384
    s_and_b32 s42, s42, 131071
    s_add_u32 s41, s41, 1
    s_branch L_ld
L_drain:
    s_add_u32 s50, s41, 1
    s_lshl_b32 s50, s50, 16
    s_add_u32 s43, s43, s50
    s_waitcnt lgkmcnt(0)
    v_min_u32 v12, v12, v13
    s_mov_b32 s52, 524288
    v_readfirstlane_b32 s50, v12
    s_cmp_ge_u32 s50, s51
    s_cbranch_scc1 L_freeb
L_wfreeb:
    ds_read_b64 v[12:13], v9 offset:8
    s_sub_u32 s52, s52, 1
    s_cbranch_scc1 L_freeb
    s_waitcnt lgkmcnt(0)
    v_min_u32 v12, v12, v13
    s_nop 0
    v_readfirstlane_b32 s50, v12
    s_cmp_ge_u32 s50, s51
    s_cbranch_scc0 L_wfreeb
L_freeb:
    s_load_dword s36, s[18:19], 0
    s_add_u32 m0, s42, 8192
    s_add_u32 s45, s39, 0
    s_waitcnt vmcnt(20)
    buffer_load_dwordx4 v6, s[24:27], s45 offen offset:0 nt lds
    s_waitcnt vmcnt(20)
    buffer_load_dwordx4 v6, s[24:27], s45 offen offset:1024 nt lds
    s_waitcnt vmcnt(20)
    buffer_load_dwordx4 v6, s[24:27], s45 offen offset:2048 nt lds
    s_waitcnt vmcnt(20)
    buffer_load_dwordx4 v6, s[24:27], s45 offen offset:3072 nt lds
    s_add_u32 m0, s42, 12288
    s_add_u32 s45, s39, 32768
    s_waitcnt vmcnt(20)
    buffer_load_dwordx4 v6, s[24:27], s45 offen offset:0 nt lds
    s_add_u32 s43, s43, 1
    v_max_i32 v11, s43, v11
    ds_write_b32 v10, v11
    s_waitcnt vmcnt(20)
    buffer_load_dwordx4 v6, s[24:27], s45 offen offset:1024 nt lds
    s_waitcnt vmcnt(20)
    buffer_load_dwordx4 v6, s[24:27], s45 offen offset:2048 nt lds
    s_waitcnt vmcnt(20)
    buffer_load_dwordx4 v6, s[24:27], s45 offen offset:3072 nt lds
    s_mov_b32 s48, 0
    v_bfe_u32 v24, v0, 3, 2
    v_bfe_u32 v25, v0, 2, 1
    v_lshrrev_b32 v26, 5, v0
    v_add_u32 v26, s48, v26
    v_lshlrev_b32 v25, 10, v25
    v_lshl_add_u32 v25, v24, 8, v25
    v_lshl_add_u32 v25, v26, 6, v25
    v_and_b32 v27, 3, v0
    v_lshl_add_u32 v25, v27, 4, v25
    v_and_b32 v27, 7, v0
    v_lshlrev_b32 v27, 4, v27
    v_lshl_add_u32 v28, v26, 14, v27
    v_lshl_add_u32 v28, v24, 12, v28
    s_lshl_b32 s54, s34, 3
    s_add_u32 s54, s54, s33
    s_lshl_b32 s41, s35, 16
    s_lshl_b32 s45, s54, 7
    s_add_u32 s41, s41, s45
    s_add_u32 s41, s41, 1048576
    v_add_u32 v28, s41, v28
    s_waitcnt vmcnt(16)
    s_add_u32 s43, s43, 1
    v_max_i32 v11, s43, v11
    ds_write_b32 v10, v11
    s_waitcnt vmcnt(8)
    s_add_u32 s43, s43, 1
    v_max_i32 v11, s43, v11
    ds_write_b32 v10, v11
L_publish:
    v_lshl_add_u32 v34, v26, 15, v27
    v_lshl_add_u32 v34, v24, 13, v34
    s_lshl_b32 s41, s34, 10
    s_and_b32 s45, s2, 63
    s_add_u32 s41, s41, s45
    s_lshl_b32 s41, s41, 7
    s_add_u32 s41, s41, 1572864
    v_add_u32 v34, s41, v34
    v_add_u32 v25, 131072, v25
    v_lshlrev_b32 v27, 3, v26
    v_add_u32 v27, 139264, v27
    v_mov_b32 v29, 0xffffff00
    s_mov_b32 s56, 0x07060501
    s_mov_b32 s57, 0x07060502
    s_mov_b32 s58, 0x07060503
    s_waitcnt lgkmcnt(0)
    s_add_u32 s36, s36, 1
    s_and_b32 s53, s36, 0xff
    s_waitcnt vmcnt(0)
    s_barrier
    ds_read_b64 v[44:45], v27 offset:0
    ds_read_b64 v[46:47], v27 offset:32
    ds_read_b64 v[48:49], v27 offset:64
    ds_read_b64 v[50:51], v27 offset:96
    s_waitcnt lgkmcnt(0)
    v_max3_f32 v30, v44, v46, v48
    v_max_f32 v30, v30, v50
    v_sub_f32 v52, v44, v30
    v_sub_f32 v54, v46, v30
    v_sub_f32 v56, v48, v30
    v_sub_f32 v58, v50, v30
    v_exp_f32 v52, v52
    v_exp_f32 v54, v54
    v_exp_f32 v56, v56
    v_exp_f32 v58, v58
    s_nop 0
    v_mul_f32 v31, v45, v52
    v_fmac_f32 v31, v47, v54
    v_fmac_f32 v31, v49, v56
    v_fmac_f32 v31, v51, v58
    v_rcp_f32 v32, v31
    v_log_f32 v31, v31
    s_nop 0
    v_mul_f32 v52, v52, v32
    v_mul_f32 v54, v54, v32
    v_mul_f32 v56, v56, v32
    v_mul_f32 v58, v58, v32
    v_add_f32 v30, v30, v31
    v_and_or_b32 v83, v30, v29, s53
    s_barrier
    ds_read_b128 v[60:63], v25 offset:0
    ds_read_b128 v[64:67], v25 offset:2048
    ds_read_b128 v[68:71], v25 offset:4096
    ds_read_b128 v[72:75], v25 offset:6144
    s_waitcnt lgkmcnt(3)
    v_pk_mul_f32 v[76:77], v[60:61], v[52:53] op_sel_hi:[1,0]
    v_pk_mul_f32 v[78:79], v[62:63], v[52:53] op_sel_hi:[1,0]
    s_waitcnt lgkmcnt(2)
    v_pk_fma_f32 v[76:77], v[64:65], v[54:55], v[76:77] op_sel_hi:[1,0,1]
    v_pk_fma_f32 v[78:79], v[66:67], v[54:55], v[78:79] op_sel_hi:[1,0,1]
    s_waitcnt lgkmcnt(1)
    v_pk_fma_f32 v[76:77], v[68:69], v[56:57], v[76:77] op_sel_hi:[1,0,1]
    v_pk_fma_f32 v[78:79], v[70:71], v[56:57], v[78:79] op_sel_hi:[1,0,1]
    s_waitcnt lgkmcnt(0)
    v_pk_fma_f32 v[76:77], v[72:73], v[58:59], v[76:77] op_sel_hi:[1,0,1]
    v_pk_fma_f32 v[78:79], v[74:75], v[58:59], v[78:79] op_sel_hi:[1,0,1]
    v_perm_b32 v80, v76, v79, s56
    v_perm_b32 v81, v77, v79, s57
    v_perm_b32 v82, v78, v79, s58
    global_store_dwordx4 v28, v[80:83], s[18:19] sc1
    s_mov_b32 exec_lo, 0x01010101
    s_mov_b32 exec_hi, 0x01010101
    global_load_dword v35, v34, s[18:19]
    s_mov_b64 exec, -1
    s_waitcnt vmcnt(1)
    s_barrier
    s_waitcnt vmcnt(0)
    s_endpgm
L_cons:
    v_lshrrev_b32 v7, 4, v0
    v_and_b32 v21, 15, v0
    v_and_b32 v22, 3, v0
    v_bfe_u32 v23, v0, 2, 2
    s_cmp_lg_u32 s3, 0
    s_cbranch_scc1 L_noq
    s_lshr_b32 s43, s34, 1
    s_lshl_b32 s43, s43, 9
    v_lshlrev_b32 v25, 10, v22
    v_lshl_add_u32 v25, v23, 6, v25
    v_lshl_add_u32 v25, v7, 4, v25
    v_add_u32 v25, s43, v25
    s_waitcnt lgkmcnt(0)
    global_load_dwordx4 v[44:47], v25, s[4:5] offset:0
    global_load_dwordx4 v[48:51], v25, s[4:5] offset:256
    s_branch L_st
L_noq:
    s_cmp_lg_u32 s3, 1
    s_cbranch_scc1 L_st
    s_cmp_lg_u32 s33, 0
    s_cbranch_scc1 L_st
    s_lshl_b32 s42, s32, 10
    s_add_u32 s42, s42, 32768
    v_lshl_add_u32 v26, v0, 2, s42
    v_mov_b32 v80, 0
    s_waitcnt lgkmcnt(0)
    s_mov_b32 exec_hi, 0
    global_store_dword v26, v80, s[18:19] sc1
    s_mov_b64 exec, -1
L_st:
    s_waitcnt lgkmcnt(0)
    s_load_dword s36, s[18:19], 0
    s_and_b32 s43, s3, 1
    s_lshl_b32 s43, s43, 12
    v_xor_b32 v24, v7, v22
    v_lshlrev_b32 v24, 4, v24
    v_lshl_add_u32 v24, v21, 8, v24
    v_add_u32 v24, s43, v24
    v_xor_b32 v25, 0, v23
    v_lshl_add_u32 v2, v25, 6, v24
    v_xor_b32 v25, 1, v23
    v_lshl_add_u32 v3, v25, 6, v24
    v_xor_b32 v25, 2, v23
    v_lshl_add_u32 v4, v25, 6, v24
    v_xor_b32 v25, 3, v23
    v_lshl_add_u32 v5, v25, 6, v24
    v_lshlrev_b32 v6, 10, v7
    v_lshl_add_u32 v6, v21, 4, v6
    v_add_u32 v6, s43, v6
    v_mov_b32 v24, 0xffff
    v_mov_b32 v25, 0xffff0000
    v_mov_b32 v13, 0
    v_mov_b32 v14, 0
    v_cmp_eq_u32 vcc, 0, v22
    s_nop 1
    v_cndmask_b32 v13, v13, v24, vcc
    v_cmp_eq_u32 vcc, 1, v22
    s_nop 1
    v_cndmask_b32 v13, v13, v25, vcc
    v_cmp_eq_u32 vcc, 2, v22
    s_nop 1
    v_cndmask_b32 v14, v14, v24, vcc
    v_cmp_eq_u32 vcc, 3, v22
    s_nop 1
    v_cndmask_b32 v14, v14, v25, vcc
    v_mov_b32 v15, 0xff800000
    v_mov_b32 v16, 0xff800000
    v_mov_b32 v17, 0
    v_mov_b32 v18, 1
    v_mov_b32 v19, 147456
    v_mov_b32 v88, 0
    v_mov_b32 v89, 0
    v_mov_b32 v90, 0
    v_mov_b32 v91, 0
    v_mov_b32 v92, 0
    v_mov_b32 v93, 0
    v_mov_b32 v94, 0
    v_mov_b32 v95, 0
    s_mov_b32 s37, 0x3e0293ee
    s_waitcnt lgkmcnt(0)
    s_add_u32 s36, s36, 1
    s_and_b32 s53, s36, 0xff
    s_cmp_eq_u32 s3, 0
    s_cbranch_scc1 L_qprod
    s_cmp_lg_u32 s3, 1
    s_cbranch_scc1 L_qgather
    s_waitcnt vmcnt(0)
    ds_write_b32 v19, v18 offset:132
    s_branch L_qgather
L_qprod:
    v_lshl_add_u32 v24, v7, 3, v23
    v_lshlrev_b32 v24, 6, v24
    v_lshl_add_u32 v24, v22, 3, v24
    v_add_u32 v24, 131072, v24
    s_mov_b32 s44, 524288
L_wqw:
    ds_read_b32 v20, v19 offset:0
    s_sub_u32 s44, s44, 1
    s_cbranch_scc1 L_wqw_x
    s_waitcnt lgkmcnt(0)
    v_readfirstlane_b32 s49, v20
    s_cmp_ge_u32 s49, 2
    s_cbranch_scc0 L_wqw
L_wqw_x:
    ds_read_b64_tr_b16 v[112:113], v24 offset:0
    ds_read_b64_tr_b16 v[114:115], v24 offset:256
    ds_read_b64_tr_b16 v[116:117], v24 offset:32
    ds_read_b64_tr_b16 v[118:119], v24 offset:288
    ds_read_b64_tr_b16 v[120:121], v24 offset:2048
    ds_read_b64_tr_b16 v[122:123], v24 offset:2304
    ds_read_b64_tr_b16 v[124:125], v24 offset:2080
    ds_read_b64_tr_b16 v[126:127], v24 offset:2336
    s_waitcnt vmcnt(0)
    ds_read_b64_tr_b16 v[128:129], v24 offset:4096
    ds_read_b64_tr_b16 v[130:131], v24 offset:4352
    ds_read_b64_tr_b16 v[132:133], v24 offset:4128
    ds_read_b64_tr_b16 v[134:135], v24 offset:4384
    ds_read_b64_tr_b16 v[136:137], v24 offset:6144
    ds_read_b64_tr_b16 v[138:139], v24 offset:6400
    ds_read_b64_tr_b16 v[140:141], v24 offset:6176
    ds_read_b64_tr_b16 v[142:143], v24 offset:6432
    s_waitcnt lgkmcnt(8)
    v_mfma_f32_16x16x32_bf16 v[64:67], v[112:115], v[44:47], 0
    v_mfma_f32_16x16x32_bf16 v[80:83], v[116:119], v[44:47], 0
    v_mfma_f32_16x16x32_bf16 v[68:71], v[120:123], v[44:47], 0
    v_mfma_f32_16x16x32_bf16 v[84:87], v[124:127], v[44:47], 0
    ds_read_b64_tr_b16 v[144:145], v24 offset:8192
    ds_read_b64_tr_b16 v[146:147], v24 offset:8448
    ds_read_b64_tr_b16 v[148:149], v24 offset:8224
    ds_read_b64_tr_b16 v[150:151], v24 offset:8480
    ds_read_b64_tr_b16 v[152:153], v24 offset:10240
    ds_read_b64_tr_b16 v[154:155], v24 offset:10496
    ds_read_b64_tr_b16 v[156:157], v24 offset:10272
    ds_read_b64_tr_b16 v[158:159], v24 offset:10528
    s_waitcnt lgkmcnt(8)
    v_mfma_f32_16x16x32_bf16 v[72:75], v[128:131], v[44:47], 0
    v_mfma_f32_16x16x32_bf16 v[88:91], v[132:135], v[44:47], 0
    v_mfma_f32_16x16x32_bf16 v[76:79], v[136:139], v[44:47], 0
    v_mfma_f32_16x16x32_bf16 v[92:95], v[140:143], v[44:47], 0
    ds_read_b64_tr_b16 v[160:161], v24 offset:12288
    ds_read_b64_tr_b16 v[162:163], v24 offset:12544
    ds_read_b64_tr_b16 v[164:165], v24 offset:12320
    ds_read_b64_tr_b16 v[166:167], v24 offset:12576
    ds_read_b64_tr_b16 v[168:169], v24 offset:14336
    ds_read_b64_tr_b16 v[170:171], v24 offset:14592
    ds_read_b64_tr_b16 v[172:173], v24 offset:14368
    ds_read_b64_tr_b16 v[174:175], v24 offset:14624
    s_waitcnt lgkmcnt(8)
    v_mfma_f32_16x16x32_bf16 v[64:67], v[144:147], v[48:51], v[64:67]
    v_mfma_f32_16x16x32_bf16 v[80:83], v[148:151], v[48:51], v[80:83]
    v_mfma_f32_16x16x32_bf16 v[68:71], v[152:155], v[48:51], v[68:71]
    v_mfma_f32_16x16x32_bf16 v[84:87], v[156:159], v[48:51], v[84:87]
    s_waitcnt lgkmcnt(0)
    v_mfma_f32_16x16x32_bf16 v[72:75], v[160:163], v[48:51], v[72:75]
    v_mfma_f32_16x16x32_bf16 v[88:91], v[164:167], v[48:51], v[88:91]
    v_mfma_f32_16x16x32_bf16 v[76:79], v[168:171], v[48:51], v[76:79]
    v_mfma_f32_16x16x32_bf16 v[92:95], v[172:175], v[48:51], v[92:95]
    v_lshlrev_b32 v25, 15, v22
    v_lshl_add_u32 v25, v23, 6, v25
    v_lshl_add_u32 v25, v7, 4, v25
    s_lshl_b32 s41, s35, 12
    s_lshr_b32 s42, s34, 1
    s_lshl_b32 s42, s42, 11
    s_add_u32 s41, s41, s42
    s_lshl_b32 s42, s33, 8
    s_add_u32 s41, s41, s42
    s_and_b32 s42, s34, 1
    s_lshl_b32 s42, s42, 7
    s_add_u32 s41, s41, s42
    s_add_u32 s41, s41, 65536
    v_add_u32 v25, s41, v25
    v_mov_b32 v27, 0xffffff00
    v_add_f32_dpp v60, v68, v64 row_shl:4 row_mask:0xf bank_mask:0x1
    v_add_f32_dpp v61, v69, v65 row_shl:4 row_mask:0xf bank_mask:0x1
    v_add_f32_dpp v62, v70, v66 row_shl:4 row_mask:0xf bank_mask:0x1
    v_add_f32_dpp v63, v71, v67 row_shl:4 row_mask:0xf bank_mask:0x1
    v_add_f32_dpp v60, v80, v84 row_shr:4 row_mask:0xf bank_mask:0x2
    v_add_f32_dpp v61, v81, v85 row_shr:4 row_mask:0xf bank_mask:0x2
    v_add_f32_dpp v62, v82, v86 row_shr:4 row_mask:0xf bank_mask:0x2
    v_add_f32_dpp v63, v83, v87 row_shr:4 row_mask:0xf bank_mask:0x2
    v_add_f32_dpp v60, v72, v60 row_shl:8 row_mask:0xf bank_mask:0x1
    v_add_f32_dpp v61, v73, v61 row_shl:8 row_mask:0xf bank_mask:0x1
    v_add_f32_dpp v62, v74, v62 row_shl:8 row_mask:0xf bank_mask:0x1
    v_add_f32_dpp v63, v75, v63 row_shl:8 row_mask:0xf bank_mask:0x1
    v_add_f32_dpp v60, v88, v60 row_shl:4 row_mask:0xf bank_mask:0x2
    v_add_f32_dpp v61, v89, v61 row_shl:4 row_mask:0xf bank_mask:0x2
    v_add_f32_dpp v62, v90, v62 row_shl:4 row_mask:0xf bank_mask:0x2
    v_add_f32_dpp v63, v91, v63 row_shl:4 row_mask:0xf bank_mask:0x2
    v_add_f32_dpp v60, v76, v60 row_shl:12 row_mask:0xf bank_mask:0x1
    v_add_f32_dpp v61, v77, v61 row_shl:12 row_mask:0xf bank_mask:0x1
    v_add_f32_dpp v62, v78, v62 row_shl:12 row_mask:0xf bank_mask:0x1
    v_add_f32_dpp v63, v79, v63 row_shl:12 row_mask:0xf bank_mask:0x1
    v_add_f32_dpp v60, v92, v60 row_shl:8 row_mask:0xf bank_mask:0x2
    v_add_f32_dpp v61, v93, v61 row_shl:8 row_mask:0xf bank_mask:0x2
    v_add_f32_dpp v62, v94, v62 row_shl:8 row_mask:0xf bank_mask:0x2
    v_add_f32_dpp v63, v95, v63 row_shl:8 row_mask:0xf bank_mask:0x2
    v_mov_b32 v88, 0
    v_mov_b32 v89, 0
    v_mov_b32 v90, 0
    v_mov_b32 v91, 0
    v_mov_b32 v92, 0
    v_mov_b32 v93, 0
    v_mov_b32 v94, 0
    v_mov_b32 v95, 0
    v_and_or_b32 v60, v60, v27, s53
    v_and_or_b32 v61, v61, v27, s53
    v_and_or_b32 v62, v62, v27, s53
    v_and_or_b32 v63, v63, v27, s53
    s_mov_b32 s44, 524288
L_pww:
    ds_read_b32 v20, v19 offset:132
    s_sub_u32 s44, s44, 1
    s_cbranch_scc1 L_pww_x
    s_waitcnt lgkmcnt(0)
    v_readfirstlane_b32 s49, v20
    s_cmp_lg_u32 s49, 0
    s_cbranch_scc0 L_pww
L_pww_x:
    s_mov_b32 exec_lo, 0x00ff00ff
    s_mov_b32 exec_hi, 0x00ff00ff
    global_store_dwordx4 v25, v[60:63], s[18:19] sc1
    s_mov_b64 exec, -1
L_qgather:
    v_and_b32 v25, 31, v0
    v_lshlrev_b32 v24, 4, v25
    v_lshrrev_b32 v26, 5, v0
    v_lshl_add_u32 v24, v26, 11, v24
    s_lshl_b32 s41, s32, 12
    s_lshl_b32 s42, s3, 9
    s_add_u32 s41, s41, s42
    s_add_u32 s41, s41, 65536
    v_add_u32 v148, s41, v24
    s_lshl_b32 s42, s3, 8
    s_add_u32 s42, s42, 148480
    v_lshl_add_u32 v149, v25, 3, s42
    s_lshl_b32 s40, s35, 2
    s_lshr_b32 s45, s33, 1
    s_add_u32 s40, s40, s45
    s_and_b32 s42, s33, 1
    v_lshlrev_b32 v20, 4, v0
    s_lshl_b32 s43, s3, 11
    v_add_u32 v115, s43, v20
    v_add_u32 v112, 131072, v115
    s_lshl_b32 s43, s3, 5
    s_add_u32 s43, s43, 139264
    v_lshl_add_u32 v113, v23, 3, s43
    s_and_b32 s43, s3, 1
    s_lshl_b32 s43, s43, 1
    v_bfe_u32 v24, v0, 3, 2
    v_bfe_u32 v25, v0, 2, 1
    v_lshrrev_b32 v26, 5, v0
    v_add_u32 v26, s43, v26
    v_lshlrev_b32 v25, 10, v25
    v_lshl_add_u32 v25, v24, 8, v25
    v_lshl_add_u32 v25, v26, 6, v25
    v_and_b32 v27, 3, v0
    v_lshl_add_u32 v25, v27, 4, v25
    v_and_b32 v27, 7, v0
    v_lshlrev_b32 v27, 4, v27
    v_mov_b32 v116, v25
    v_lshl_add_u32 v117, v26, 15, v27
    v_lshl_add_u32 v117, v24, 13, v117
    s_lshl_b32 s41, s34, 10
    s_and_b32 s45, s2, 63
    s_add_u32 s41, s41, s45
    s_lshl_b32 s41, s41, 7
    s_add_u32 s41, s41, 1572864
    v_add_u32 v117, s41, v117
    v_lshl_add_u32 v24, v23, 3, v22
    v_lshlrev_b32 v24, 7, v24
    v_lshl_add_u32 v24, v7, 4, v24
    s_lshl_b32 s41, s40, 2
    s_lshl_b32 s45, s42, 1
    s_add_u32 s41, s41, s45
    s_lshr_b32 s45, s3, 1
    s_add_u32 s41, s41, s45
    s_lshl_b32 s46, s41, 5
    s_lshl_b32 s41, s41, 12
    s_and_b32 s45, s3, 1
    s_lshl_b32 s43, s45, 2
    s_add_u32 s46, s46, s43
    s_lshl_b32 s45, s45, 6
    s_add_u32 s41, s41, s45
    s_add_u32 s41, s41, 1048576
    v_add_u32 v114, s41, v24
    s_lshl_b32 s46, s46, 10
    s_lshl_b32 s45, s34, 8
    s_add_u32 s46, s46, s45
    v_lshlrev_b32 v122, 10, v7
    v_lshl_add_u32 v122, v21, 4, v122
    v_add_u32 v122, s46, v122
    v_lshrrev_b32 v24, 1, v0
    v_lshlrev_b32 v24, 7, v24
    v_and_b32 v25, 1, v0
    v_lshl_add_u32 v24, v25, 4, v24
    s_and_b32 s41, s2, 31
    s_lshl_b32 s41, s41, 1
    s_bfe_u32 s45, s2, 0x10005
    s_add_u32 s46, s41, s45
    s_lshl_b32 s41, s46, 13
    s_lshl_b32 s45, s34, 5
    s_add_u32 s41, s41, s45
    s_add_u32 s41, s41, 1572864
    v_add_u32 v118, s41, v24
    v_add_u32 v119, 0x1000, v118
    s_bfe_u32 s41, s46, 0x20002
    s_lshl_b32 s41, s41, 10
    s_bfe_u32 s45, s46, 0x20004
    s_lshl_b32 s45, s45, 8
    s_add_u32 s41, s41, s45
    s_and_b32 s45, s46, 3
    s_lshl_b32 s45, s45, 6
    s_add_u32 s41, s41, s45
    s_lshl_b32 s45, s34, 2
    s_add_u32 s41, s41, s45
    v_and_b32 v24, 1, v7
    v_lshlrev_b32 v24, 5, v24
    v_lshrrev_b32 v25, 1, v7
    v_lshl_add_u32 v24, v25, 4, v24
    v_add_u32 v120, s41, v24
    v_mov_b32 v121, 0xffffff00
    s_mov_b32 s57, 0x0c04000c
    s_mov_b32 s58, 0x04020100
    s_mov_b32 s44, 524288
L_qdel:
    ds_read_b32 v20, v19 offset:0
    s_sub_u32 s44, s44, 1
    s_cbranch_scc1 L_qdel_x
    s_waitcnt lgkmcnt(0)
    v_readfirstlane_b32 s49, v20
    s_cmp_ge_u32 s49, 8
    s_cbranch_scc0 L_qdel
L_qdel_x:
L_qpoll:
    global_load_dwordx4 v[44:47], v148, s[18:19] sc1
    s_sub_u32 s44, s44, 1
    s_cbranch_scc1 L_qpoll_x
    s_waitcnt vmcnt(0)
    v_xor_b32 v68, s53, v44
    v_xor_b32 v69, s53, v45
    v_xor_b32 v70, s53, v46
    v_xor_b32 v71, s53, v47
    v_or3_b32 v68, v68, v69, v70
    v_or_b32 v68, v68, v71
    v_and_b32 v68, 0xff, v68
    v_cmp_ne_u32 vcc, 0, v68
    s_and_b64 exec, exec, vcc
    s_cbranch_scc1 L_qpoll
L_qpoll_x:
    s_mov_b64 exec, -1
    s_waitcnt vmcnt(0)
    v_mov_b32 v48, v44
    v_mov_b32 v49, v45
    v_mov_b32 v50, v46
    v_mov_b32 v51, v47
    v_permlane32_swap_b32 v44, v48
    v_permlane32_swap_b32 v45, v49
    v_permlane32_swap_b32 v46, v50
    v_permlane32_swap_b32 v47, v51
    v_add_f32 v44, v44, v48
    v_add_f32 v45, v45, v49
    v_add_f32 v46, v46, v50
    v_add_f32 v47, v47, v51
    v_cvt_pk_bf16_f32 v44, v44, v45
    v_cvt_pk_bf16_f32 v45, v46, v47
    ds_write_b64 v149, v[44:45]
    v_lshlrev_b32 v24, 8, v23
    v_lshl_add_u32 v24, v7, 4, v24
    v_add_u32 v24, 148480, v24
    s_mov_b64 exec, 1
    ds_add_u32 v19, v18 offset:128
    s_mov_b64 exec, -1
L_qw:
    ds_read_b32 v20, v19 offset:128
    s_sub_u32 s44, s44, 1
    s_cbranch_scc1 L_qw_x
    s_waitcnt lgkmcnt(0)
    v_readfirstlane_b32 s49, v20
    s_cmp_ge_u32 s49, 4
    s_cbranch_scc0 L_qw
L_qw_x:
    ds_read_b128 v[28:31], v24 offset:0
    ds_read_b128 v[32:35], v24 offset:64
    ds_read_b128 v[36:39], v24 offset:128
    ds_read_b128 v[40:43], v24 offset:192
    s_lshr_b32 s47, s3, 1
    s_lshl_b32 s48, s47, 14
    s_add_u32 s39, s47, 2
    s_mov_b32 s49, 0
    s_mov_b32 s55, 0
L_blk:
    v_add_u32 v8, s48, v2
    v_add_u32 v9, s48, v3
    v_add_u32 v10, s48, v4
    v_add_u32 v11, s48, v5
    s_add_u32 s50, s48, 16384
    s_and_b32 s50, s50, 131071
    s_lshr_b32 s54, s50, 11
    s_add_u32 s50, s50, 8192
    v_add_u32 v12, s50, v6
    s_cmp_gt_u32 s49, s39
    s_cbranch_scc1 L_kok
    s_mov_b32 s44, 524288
L_kpoll:
    s_lshr_b32 s55, s55, 16
    s_sub_u32 s55, s55, 1
    s_cmp_ge_u32 s47, s55
    s_cbranch_scc1 L_loopend
    ds_read_b32 v20, v19
    s_sub_u32 s44, s44, 1
    s_cbranch_scc1 L_loopend
    s_waitcnt lgkmcnt(0)
    v_readfirstlane_b32 s55, v20
    s_and_b32 s49, s55, 0xffff
    s_cmp_gt_u32 s49, s39
    s_cbranch_scc0 L_kpoll
L_kok:
    ds_read_b128 v[44:47], v8
    ds_read_b128 v[48:51], v9
    ds_read_b128 v[52:55], v10
    ds_read_b128 v[56:59], v11
    s_lshr_b32 s51, s48, 11
    s_lshl_b32 s39, s47, 1
    s_add_u32 s39, s39, 4
    v_add_u32 v21, s51, v19
    v_add_u32 v123, s54, v19
    s_waitcnt lgkmcnt(3)
    v_mfma_f32_16x16x32_bf16 v[76:79], v[44:47], v[28:31], 0
    s_waitcnt lgkmcnt(2)
    v_mfma_f32_16x16x32_bf16 v[76:79], v[48:51], v[32:35], v[76:79]
    s_waitcnt lgkmcnt(1)
    v_mfma_f32_16x16x32_bf16 v[76:79], v[52:55], v[36:39], v[76:79]
    s_waitcnt lgkmcnt(0)
    v_mfma_f32_16x16x32_bf16 v[76:79], v[56:59], v[40:43], v[76:79]
    s_mov_b64 exec, 1
    ds_add_u32 v21, v18 offset:8
    s_mov_b64 exec, -1
    s_cmp_gt_u32 s49, s39
    s_cbranch_scc1 L_vok
    s_nop 2
    v_max3_f32 v20, v76, v77, v78
    v_max_f32 v20, v20, v79
    v_cmp_gt_f32 vcc, v20, v15
    s_cbranch_vccz L_nomax1
    s_mov_b32 s52, 1
    s_branch L_newmax
L_nomax1:
    v_fma_f32 v76, v76, s37, -v16
    v_fma_f32 v77, v77, s37, -v16
    v_fma_f32 v78, v78, s37, -v16
    v_fma_f32 v79, v79, s37, -v16
    v_exp_f32 v76, v76
    v_exp_f32 v77, v77
    v_exp_f32 v78, v78
    v_exp_f32 v79, v79
    s_nop 0
    v_cvt_pk_bf16_f32 v24, v76, v76
    v_cvt_pk_bf16_f32 v25, v77, v77
    v_cvt_pk_bf16_f32 v26, v78, v78
    v_cvt_pk_bf16_f32 v27, v79, v79
    v_add_f32 v76, v76, v77
    v_add_f32 v78, v78, v79
    v_and_b32 v80, v24, v13
    v_and_b32 v81, v24, v14
    v_and_b32 v82, v25, v13
    v_and_b32 v83, v25, v14
    v_and_b32 v84, v26, v13
    v_and_b32 v85, v26, v14
    v_and_b32 v86, v27, v13
    v_and_b32 v87, v27, v14
    v_add_f32 v76, v76, v78
    v_add_f32 v17, v17, v76
    s_mov_b32 s44, 524288
    s_add_u32 s50, s47, 2
    s_mov_b32 s38, 1
L_vpoll:
    s_lshr_b32 s55, s55, 16
    s_cmp_eq_u32 s55, s50
    s_cbranch_scc1 L_fin1
    ds_read_b32 v20, v19
    s_sub_u32 s44, s44, 1
    s_cbranch_scc1 L_vok1
    s_waitcnt lgkmcnt(0)
    v_readfirstlane_b32 s55, v20
    s_and_b32 s49, s55, 0xffff
    s_cmp_gt_u32 s49, s39
    s_cbranch_scc0 L_vpoll
L_vok1:
    ds_read_b128 v[60:63], v12 offset:0
    ds_read_b128 v[64:67], v12 offset:256
    ds_read_b128 v[68:71], v12 offset:512
    ds_read_b128 v[72:75], v12 offset:768
    s_branch L_pv
L_vok:
    ds_read_b128 v[60:63], v12 offset:0
    ds_read_b128 v[64:67], v12 offset:256
    ds_read_b128 v[68:71], v12 offset:512
    ds_read_b128 v[72:75], v12 offset:768
    v_max3_f32 v20, v76, v77, v78
    v_max_f32 v20, v20, v79
    v_cmp_gt_f32 vcc, v20, v15
    s_cbranch_vccz L_nomax2
    s_mov_b32 s52, 0
L_newmax:
    v_mov_b32 v24, v20
    s_nop 1
    v_permlane16_swap_b32 v20, v24
    s_nop 0
    v_max_f32 v20, v20, v24
    v_mov_b32 v24, v20
    s_nop 1
    v_permlane32_swap_b32 v20, v24
    s_nop 0
    v_max3_f32 v20, v20, v24, v15
    v_sub_f32 v24, v15, v20
    v_mul_f32 v24, s37, v24
    v_exp_f32 v24, v24
    v_mov_b32 v15, v20
    v_mul_f32 v16, s37, v20
    v_mul_f32 v17, v17, v24
    v_mul_f32 v88, v88, v24
    v_mul_f32 v89, v89, v24
    v_mul_f32 v90, v90, v24
    v_mul_f32 v91, v91, v24
    v_mul_f32 v92, v92, v24
    v_mul_f32 v93, v93, v24
    v_mul_f32 v94, v94, v24
    v_mul_f32 v95, v95, v24
    s_cmp_eq_u32 s52, 1
    s_cbranch_scc1 L_nomax1
L_nomax2:
    v_fma_f32 v76, v76, s37, -v16
    v_fma_f32 v77, v77, s37, -v16
    v_fma_f32 v78, v78, s37, -v16
    v_fma_f32 v79, v79, s37, -v16
    v_exp_f32 v76, v76
    v_exp_f32 v77, v77
    v_exp_f32 v78, v78
    v_exp_f32 v79, v79
    s_nop 0
    v_cvt_pk_bf16_f32 v24, v76, v76
    v_cvt_pk_bf16_f32 v25, v77, v77
    v_cvt_pk_bf16_f32 v26, v78, v78
    v_cvt_pk_bf16_f32 v27, v79, v79
    v_add_f32 v76, v76, v77
    v_add_f32 v78, v78, v79
    v_and_b32 v80, v24, v13
    v_and_b32 v81, v24, v14
    v_and_b32 v82, v25, v13
    v_and_b32 v83, v25, v14
    v_and_b32 v84, v26, v13
    v_and_b32 v85, v26, v14
    v_and_b32 v86, v27, v13
    v_and_b32 v87, v27, v14
    v_add_f32 v76, v76, v78
    v_add_f32 v17, v17, v76
L_pv:
    s_add_u32 s47, s47, 2
    s_add_u32 s39, s39, 1
    s_add_u32 s48, s48, 32768
    s_and_b32 s48, s48, 131071
    s_waitcnt lgkmcnt(3)
    v_mfma_f32_16x16x16_bf16 v[88:91], v[60:61], v[80:81], v[88:91]
    v_mfma_f32_16x16x16_bf16 v[92:95], v[62:63], v[80:81], v[92:95]
    s_waitcnt lgkmcnt(2)
    v_mfma_f32_16x16x16_bf16 v[88:91], v[64:65], v[82:83], v[88:91]
    v_mfma_f32_16x16x16_bf16 v[92:95], v[66:67], v[82:83], v[92:95]
    s_waitcnt lgkmcnt(1)
    v_mfma_f32_16x16x16_bf16 v[88:91], v[68:69], v[84:85], v[88:91]
    v_mfma_f32_16x16x16_bf16 v[92:95], v[70:71], v[84:85], v[92:95]
    s_waitcnt lgkmcnt(0)
    v_mfma_f32_16x16x16_bf16 v[88:91], v[72:73], v[86:87], v[88:91]
    v_mfma_f32_16x16x16_bf16 v[92:95], v[74:75], v[86:87], v[92:95]
    s_mov_b64 exec, 1
    ds_add_u32 v123, v18 offset:12
    s_mov_b64 exec, -1
    s_branch L_blk
L_loopend:
    s_mov_b32 s38, 0
    ds_write_b128 v112, v[88:91]
    ds_write_b128 v112, v[92:95] offset:1024
L_fin1:
    v_mov_b32 v24, v17
    s_mov_b32 s44, 524288
    s_cmp_eq_u32 s38, 0
    v_permlane16_swap_b32 v17, v24
    s_nop 0
    v_add_f32 v17, v17, v24
    v_mov_b32 v24, v17
    s_nop 1
    v_permlane32_swap_b32 v17, v24
    s_nop 0
    v_add_f32 v17, v17, v24
    ds_write_b64 v113, v[16:17]
    global_load_dwordx4 v[96:99], v122, s[12:13] nt
    v_add_u32 v122, 0x2000, v122
    global_load_dwordx4 v[100:103], v122, s[12:13] nt
    v_add_u32 v122, 0x2000, v122
    global_load_dwordx4 v[104:107], v122, s[12:13] nt
    v_add_u32 v122, 0x2000, v122
    global_load_dwordx4 v[108:111], v122, s[12:13] nt
    s_waitcnt lgkmcnt(0)
    s_barrier
    s_cbranch_scc1 L_fin2
    ds_read_b128 v[60:63], v12 offset:0
    ds_read_b128 v[64:67], v12 offset:256
    ds_read_b128 v[68:71], v12 offset:512
    ds_read_b128 v[72:75], v12 offset:768
    s_waitcnt lgkmcnt(3)
    v_mfma_f32_16x16x16_bf16 v[88:91], v[60:61], v[80:81], v[88:91]
    v_mfma_f32_16x16x16_bf16 v[92:95], v[62:63], v[80:81], v[92:95]
    s_waitcnt lgkmcnt(2)
    v_mfma_f32_16x16x16_bf16 v[88:91], v[64:65], v[82:83], v[88:91]
    v_mfma_f32_16x16x16_bf16 v[92:95], v[66:67], v[82:83], v[92:95]
    s_waitcnt lgkmcnt(1)
    v_mfma_f32_16x16x16_bf16 v[88:91], v[68:69], v[84:85], v[88:91]
    v_mfma_f32_16x16x16_bf16 v[92:95], v[70:71], v[84:85], v[92:95]
    s_waitcnt lgkmcnt(0)
    v_mfma_f32_16x16x16_bf16 v[88:91], v[72:73], v[86:87], v[88:91]
    v_mfma_f32_16x16x16_bf16 v[92:95], v[74:75], v[86:87], v[92:95]
    s_nop 6
    ds_write_b128 v112, v[88:91]
    ds_write_b128 v112, v[92:95] offset:1024
    s_waitcnt lgkmcnt(0)
L_fin2:
    s_barrier
    s_barrier
L_h1poll:
    global_load_dwordx4 v[52:55], v114, s[18:19] sc1
    global_load_dwordx4 v[56:59], v114, s[18:19] offset:512 sc1
    s_sub_u32 s44, s44, 1
    s_cbranch_scc1 L_h1poll_x
    s_waitcnt vmcnt(0)
    v_xor_b32 v68, s53, v55
    v_xor_b32 v69, s53, v59
    v_or_b32 v68, v68, v69
    v_and_b32 v68, 0xff, v68
    v_cmp_ne_u32 vcc, 0, v68
    s_or_b32 s45, vcc_lo, vcc_hi
    s_lshr_b32 s46, s45, 16
    s_or_b32 s45, s45, s46
    s_pack_ll_b32_b16 s46, s45, s45
    s_mov_b32 s47, s46
    s_and_b64 exec, exec, s[46:47]
    s_cbranch_scc1 L_h1poll
L_h1poll_x:
    s_mov_b64 exec, -1
    s_waitcnt vmcnt(0)
    v_max_f32 v20, v55, v59
    v_perm_b32 v44, v53, v52, s57
    v_perm_b32 v45, v57, v56, s57
    v_max_f32_dpp v20, v20, v20 quad_perm:[1,0,3,2] row_mask:0xf bank_mask:0xf
    v_perm_b32 v44, v54, v44, s58
    v_perm_b32 v45, v58, v45, s58
    v_max_f32_dpp v20, v20, v20 quad_perm:[2,3,0,1] row_mask:0xf bank_mask:0xf
    v_sub_f32 v46, v55, v20
    v_sub_f32 v47, v59, v20
    v_exp_f32 v46, v46
    v_exp_f32 v47, v47
    s_mov_b32 s44, 524288
    v_mul_f32 v60, v52, v46
    v_add_f32 v20, v46, v47
    v_mul_f32 v61, v53, v46
    v_mul_f32 v62, v54, v46
    v_mul_f32 v63, v44, v46
    v_add_f32_dpp v20, v20, v20 quad_perm:[1,0,3,2] row_mask:0xf bank_mask:0xf
    v_fmac_f32 v60, v56, v47
    v_fmac_f32 v61, v57, v47
    v_add_f32_dpp v20, v20, v20 quad_perm:[2,3,0,1] row_mask:0xf bank_mask:0xf
    v_fmac_f32 v62, v58, v47
    v_fmac_f32 v63, v45, v47
    v_rcp_f32 v20, v20
    v_add_f32_dpp v60, v60, v60 quad_perm:[1,0,3,2] row_mask:0xf bank_mask:0xf
    v_add_f32_dpp v61, v61, v61 quad_perm:[1,0,3,2] row_mask:0xf bank_mask:0xf
    v_add_f32_dpp v62, v62, v62 quad_perm:[1,0,3,2] row_mask:0xf bank_mask:0xf
    v_add_f32_dpp v63, v63, v63 quad_perm:[1,0,3,2] row_mask:0xf bank_mask:0xf
    v_add_f32_dpp v60, v60, v60 quad_perm:[2,3,0,1] row_mask:0xf bank_mask:0xf
    v_add_f32_dpp v61, v61, v61 quad_perm:[2,3,0,1] row_mask:0xf bank_mask:0xf
    v_add_f32_dpp v62, v62, v62 quad_perm:[2,3,0,1] row_mask:0xf bank_mask:0xf
    v_add_f32_dpp v63, v63, v63 quad_perm:[2,3,0,1] row_mask:0xf bank_mask:0xf
    v_mul_f32 v60, v60, v20
    v_mul_f32 v61, v61, v20
    v_mul_f32 v62, v62, v20
    v_mul_f32 v63, v63, v20
    v_cvt_pk_bf16_f32 v60, v60, v60
    v_cvt_pk_bf16_f32 v61, v61, v61
    v_cvt_pk_bf16_f32 v62, v62, v62
    v_cvt_pk_bf16_f32 v63, v63, v63
    v_and_b32 v80, v60, v13
    v_and_b32 v81, v60, v14
    v_and_b32 v82, v61, v13
    v_and_b32 v83, v61, v14
    v_mfma_f32_16x16x16_bf16 v[88:91], v[96:97], v[80:81], 0
    v_mfma_f32_16x16x16_bf16 v[92:95], v[98:99], v[80:81], 0
    v_and_b32 v84, v62, v13
    v_and_b32 v85, v62, v14
    v_mfma_f32_16x16x16_bf16 v[88:91], v[100:101], v[82:83], v[88:91]
    v_mfma_f32_16x16x16_bf16 v[92:95], v[102:103], v[82:83], v[92:95]
    v_and_b32 v86, v63, v13
    v_and_b32 v87, v63, v14
    v_mfma_f32_16x16x16_bf16 v[88:91], v[104:105], v[84:85], v[88:91]
    v_mfma_f32_16x16x16_bf16 v[92:95], v[106:107], v[84:85], v[92:95]
    v_mfma_f32_16x16x16_bf16 v[88:91], v[108:109], v[86:87], v[88:91]
    v_mfma_f32_16x16x16_bf16 v[92:95], v[110:111], v[86:87], v[92:95]
    s_cmp_ge_u32 s3, 2
    s_nop 5
    ds_write_b128 v115, v[88:91]
    ds_write_b128 v115, v[92:95] offset:1024
    s_waitcnt lgkmcnt(0)
    s_barrier
    s_cbranch_scc1 L_h2
    ds_read_b128 v[60:63], v116 offset:0
    ds_read_b128 v[64:67], v116 offset:2048
    ds_read_b128 v[68:71], v116 offset:4096
    ds_read_b128 v[72:75], v116 offset:6144
    s_waitcnt lgkmcnt(2)
    v_pk_add_f32 v[60:61], v[60:61], v[64:65]
    v_pk_add_f32 v[62:63], v[62:63], v[66:67]
    s_waitcnt lgkmcnt(0)
    v_pk_add_f32 v[68:69], v[68:69], v[72:73]
    v_pk_add_f32 v[70:71], v[70:71], v[74:75]
    v_pk_add_f32 v[60:61], v[60:61], v[68:69]
    v_pk_add_f32 v[62:63], v[62:63], v[70:71]
    v_and_or_b32 v60, v60, v121, s53
    v_and_or_b32 v61, v61, v121, s53
    v_and_or_b32 v62, v62, v121, s53
    v_and_or_b32 v63, v63, v121, s53
    global_store_dwordx4 v117, v[60:63], s[18:19] sc1
    s_waitcnt vmcnt(0)
    s_barrier
    s_endpgm
L_h2:
    s_cmp_eq_u32 s3, 3
    s_barrier
    s_cbranch_scc1 L_fin
L_h2poll:
    global_load_dwordx4 v[52:55], v118, s[18:19] sc1
    global_load_dwordx4 v[56:59], v119, s[18:19] sc1
    s_sub_u32 s44, s44, 1
    s_cbranch_scc1 L_h2poll_x
    s_waitcnt vmcnt(0)
    v_xor_b32 v68, s53, v52
    v_xor_b32 v69, s53, v53
    v_xor_b32 v70, s53, v54
    v_xor_b32 v71, s53, v55
    v_xor_b32 v72, s53, v56
    v_xor_b32 v73, s53, v57
    v_xor_b32 v74, s53, v58
    v_xor_b32 v75, s53, v59
    v_or3_b32 v68, v68, v69, v70
    v_or3_b32 v71, v71, v72, v73
    v_or3_b32 v68, v68, v74, v75
    v_or_b32 v68, v68, v71
    v_and_b32 v68, 0xff, v68
    v_cmp_ne_u32 vcc, 0, v68
    s_and_b64 exec, exec, vcc
    s_cbranch_scc1 L_h2poll
L_h2poll_x:
    s_mov_b64 exec, -1
    s_waitcnt vmcnt(0)
    v_pk_add_f32 v[52:53], v[52:53], v[56:57]
    v_pk_add_f32 v[54:55], v[54:55], v[58:59]
    s_nop 0
    v_permlane32_swap_b32 v52, v53
    v_permlane32_swap_b32 v54, v55
    s_nop 0
    v_add_f32 v52, v52, v53
    v_add_f32 v54, v54, v55
    s_nop 1
    v_permlane16_swap_b32 v52, v54
    s_nop 0
    v_add_f32 v52, v52, v54
    s_nop 1
    v_add_f32_dpp v52, v52, v52 quad_perm:[2,3,0,1] row_mask:0xf bank_mask:0xf
    s_nop 1
    v_add_f32_dpp v52, v52, v52 row_ror:4 row_mask:0xf bank_mask:0xf
    s_nop 1
    v_add_f32_dpp v52, v52, v52 row_ror:8 row_mask:0xf bank_mask:0xf
    s_mov_b32 s46, 0x00010001
    s_mov_b32 s47, 0x00010001
    v_mov_b32_dpp v53, v52 quad_perm:[1,0,3,2] row_mask:0xf bank_mask:0xf
    s_mov_b64 exec, s[46:47]
    v_cvt_pk_bf16_f32 v52, v52, v53
    global_store_dword v120, v52, s[14:15]
    s_cmp_lg_u32 s2, 0
    s_cbranch_scc1 L_fin
    s_mov_b64 exec, 1
    v_mov_b32 v25, s36
    v_mov_b32 v24, 0
    global_store_dword v24, v25, s[18:19] offset:0
L_fin:
    s_endpgm
L_claimer:
    s_waitcnt lgkmcnt(0)
    s_load_dword s36, s[18:19], 0
    s_mov_b32 s48, 2
    v_bfe_u32 v24, v0, 3, 2
    v_bfe_u32 v25, v0, 2, 1
    v_lshrrev_b32 v26, 5, v0
    v_add_u32 v26, s48, v26
    v_lshlrev_b32 v25, 10, v25
    v_lshl_add_u32 v25, v24, 8, v25
    v_lshl_add_u32 v25, v26, 6, v25
    v_and_b32 v27, 3, v0
    v_lshl_add_u32 v25, v27, 4, v25
    v_and_b32 v27, 7, v0
    v_lshlrev_b32 v27, 4, v27
    v_lshl_add_u32 v28, v26, 14, v27
    v_lshl_add_u32 v28, v24, 12, v28
    s_lshl_b32 s54, s34, 3
    s_add_u32 s54, s54, s33
    s_lshl_b32 s41, s35, 16
    s_lshl_b32 s45, s54, 7
    s_add_u32 s41, s41, s45
    s_add_u32 s41, s41, 1048576
    v_add_u32 v28, s41, v28
    s_lshl_b32 s42, s32, 10
    s_add_u32 s42, s42, 32768
    s_add_u32 s28, s18, s42
    s_addc_u32 s29, s19, 0
    s_mov_b32 s30, 0
    s_lshl_b32 s38, s33, 2
    v_mov_b32 v4, 147456
    v_mov_b32 v5, 147712
    s_mov_b32 s43, 116
    s_mov_b64 exec, 1
    s_mov_b32 s44, 524288
L_cl:
    ds_read_b32 v6, v4
    s_sub_u32 s44, s44, 1
    s_cbranch_scc1 L_cl_x
    s_waitcnt lgkmcnt(0)
    v_readfirstlane_b32 s45, v6
    s_and_b32 s45, s45, 0xffff
    s_cmp_ge_u32 s45, s43
    s_cbranch_scc0 L_cl
L_pick:
    s_mov_b32 s31, s30
    s_lshr_b64 s[46:47], s[30:31], s38
    s_and_b32 s45, s46, 15
    s_mov_b32 s50, 0
    s_cmp_lt_u32 s45, 4
    s_cbranch_scc1 L_take
    s_mov_b32 s50, 32
    s_bfe_u32 s45, s46, 0x40004
    s_lshl3_add_u32 s45, s45, 1
    s_min_u32 s50, s50, s45
    s_bfe_u32 s45, s46, 0x40008
    s_lshl3_add_u32 s45, s45, 2
    s_min_u32 s50, s50, s45
    s_bfe_u32 s45, s46, 0x4000c
    s_lshl3_add_u32 s45, s45, 3
    s_min_u32 s50, s50, s45
    s_bfe_u32 s45, s46, 0x40010
    s_lshl3_add_u32 s45, s45, 4
    s_min_u32 s50, s50, s45
    s_bfe_u32 s45, s46, 0x40014
    s_lshl3_add_u32 s45, s45, 5
    s_min_u32 s50, s50, s45
    s_bfe_u32 s45, s46, 0x40018
    s_lshl3_add_u32 s45, s45, 6
    s_min_u32 s50, s50, s45
    s_bfe_u32 s45, s46, 0x4001c
    s_lshl3_add_u32 s45, s45, 7
    s_min_u32 s50, s50, s45
    s_mov_b32 s45, 513
    s_cmp_ge_u32 s50, 32
    s_cbranch_scc1 L_post
L_take:
    s_add_u32 s50, s50, s33
    s_and_b32 s50, s50, 7
    s_lshl_b32 s51, s50, 2
    s_lshl_b32 s46, 1, s51
    s_mov_b32 s30, s46
    s_atomic_add s46, s[28:29], 0x0 glc
    s_waitcnt lgkmcnt(0)
    s_add_u32 s30, s30, s46
    s_lshr_b32 s46, s46, s51
    s_and_b32 s45, s46, 15
    s_cmp_ge_u32 s45, 4
    s_cbranch_scc1 L_pick
    s_lshl3_add_u32 s45, s45, s50
    s_add_u32 s45, s45, 481
L_post:
    s_add_u32 s43, s43, 2
    v_mov_b32 v7, s45
    ds_write_b32 v5, v7
    v_add_u32 v5, 4, v5
    s_cmp_gt_u32 s45, 512
    s_cbranch_scc0 L_cl
L_cl_x:
    s_mov_b32 exec_lo, 0x01010101
    s_mov_b32 exec_hi, 0x01010101
    v_subrev_u32 v35, 0x8000, v28
    global_load_dword v40, v28, s[18:19]
    global_load_dword v41, v35, s[18:19]
    s_mov_b64 exec, -1
    s_branch L_publish
L_codeend:
    s_endpgm
.section .rodata,"a"
.p2align 6
.amdhsa_kernel standalone__gqa_block_cached__decode_kernel
  .amdhsa_next_free_vgpr 176
  .amdhsa_next_free_sgpr 64
  .amdhsa_accum_offset 176
  .amdhsa_group_segment_fixed_size 0
  .amdhsa_kernarg_size 64
  .amdhsa_user_sgpr_count 2
  .amdhsa_user_sgpr_kernarg_segment_ptr 1
  .amdhsa_system_sgpr_workgroup_id_x 1
  .amdhsa_float_denorm_mode_32 3
.end_amdhsa_kernel
```
